```python
import torch

def _softmax(x, axis=-1):
    return torch.softmax(x, dim=axis)
def _gelu(x):
    return torch.nn.functional.gelu(x, approximate="tanh")
def _silu(x):
    return torch.nn.functional.silu(x)
def _sigmoid(x):
    return torch.sigmoid(x)
def _layernorm(x, axis=-1, eps=1e-5):
    m = x.mean(dim=axis, keepdim=True)
    v = x.var(dim=axis, keepdim=True, unbiased=False)
    return (x - m) / torch.sqrt(v + eps)
def _scatter_add(tgt, idx, src, axis=0):
    return tgt.clone().index_add_(axis, idx, src)
def _segment_sum(src, seg, n):
    out = torch.zeros((n,) + src.shape[1:], dtype=src.dtype)
    return out.index_add_(0, seg, src)
def _pad(x, pw):
    flat = tuple(v for pair in reversed(pw) for v in pair)
    return torch.nn.functional.pad(x, flat)

kernel_name = 'concat_heads__sliding_block_cached__gqa_block_cached__decode'

def setup_inputs():

    _w = (lambda a: (lambda t: t.to(torch.bfloat16) if t.is_floating_point() else t)(torch.as_tensor(a)))
    def _A_setup():
        B, Sq, D = 1, 1, 576
        Hq, Hkv, Sk, Dh = 32, 16, 32768, 128
        assert Hq % Hkv == 0, (Hq, Hkv)
        return {
            "x": _w((lambda *s: torch.randn(*s, dtype=torch.bfloat16) * 0.8)(B, Sq, D)),
            "k_cache": _w((lambda *s: torch.randn(*s, dtype=torch.bfloat16) * 1.6)(B, Hkv, Sk, Dh)),
            "v_cache": _w((lambda *s: torch.randn(*s, dtype=torch.bfloat16) * 0.2)(B, Hkv, Sk, Dh)),
            "wq": _w((lambda *s: torch.randn(*s, dtype=torch.bfloat16) * 1.6)(D, Hq * Dh) * (D ** -0.5)),
            "wo": _w((lambda *s: torch.randn(*s, dtype=torch.bfloat16) * 0.2)(Hq * Dh, D) * ((Hq * Dh) ** -0.5)),
        }
    _A_in = _A_setup()

    def _B_setup():
        B, Sq, D = 1, 1, 576
        Hq, Hkv, Sk, Dh = 32, 16, 32768, 128
        assert Hq % Hkv == 0, (Hq, Hkv)
        return {
            "x": _w((lambda *s: torch.randn(*s, dtype=torch.bfloat16) * 0.8)(B, Sq, D)),
            "k_cache": _w((lambda *s: torch.randn(*s, dtype=torch.bfloat16) * 1.6)(B, Hkv, Sk, Dh)),
            "v_cache": _w((lambda *s: torch.randn(*s, dtype=torch.bfloat16) * 0.2)(B, Hkv, Sk, Dh)),
            "wq": _w((lambda *s: torch.randn(*s, dtype=torch.bfloat16) * 1.6)(D, Hq * Dh) * (D ** -0.5)),
            "wo": _w((lambda *s: torch.randn(*s, dtype=torch.bfloat16) * 0.2)(Hq * Dh, D) * ((Hq * Dh) ** -0.5)),
        }
    _B_in = _B_setup()

    return {
        "A_x": _A_in["x"],
        "A_k_cache": _A_in["k_cache"],
        "A_v_cache": _A_in["v_cache"],
        "A_wq": _A_in["wq"],
        "A_wo": _A_in["wo"],
        "B_x": _B_in["x"],
        "B_k_cache": _B_in["k_cache"],
        "B_v_cache": _B_in["v_cache"],
        "B_wq": _B_in["wq"],
        "B_wo": _B_in["wo"],
    }

def reference(A_x, A_k_cache, A_v_cache, A_wq, A_wo, B_x, B_k_cache, B_v_cache, B_wq, B_wo):
    def _A_ref(x, k_cache, v_cache, wq, wo):
        B, Sq, D = x.shape
        Hq, Dh = 32, 128
        Hkv, Sk = k_cache.shape[1], k_cache.shape[2]
        W = min(4096, max(256, Sk // 4))
        rep = Hq // Hkv
        q = (lambda x, *d: x.permute(*d))((x @ wq).reshape(B, Sq, Hq, Dh), 0, 2, 1, 3)
        k = (lambda x, n, axis: torch.repeat_interleave(x, n, dim=axis))(k_cache[:, :, Sk - W:, :], rep, axis=1)
        v = (lambda x, n, axis: torch.repeat_interleave(x, n, dim=axis))(v_cache[:, :, Sk - W:, :], rep, axis=1)
        scores = torch.einsum("bhqd,bhkd->bhqk", q, k) * (Dh ** -0.5)
        p = _softmax(scores, axis=-1)
        o = torch.einsum("bhqk,bhkd->bhqd", p, v)
        return (lambda x, *d: x.permute(*d))(o, 0, 2, 1, 3).reshape(B, Sq, Hq * Dh) @ wo

    def _B_ref(x, k_cache, v_cache, wq, wo):
        B, Sq, D = x.shape
        Hq, Dh = 32, 128
        Hkv = k_cache.shape[1]
        rep = Hq // Hkv
        q = (lambda x, *d: x.permute(*d))((x @ wq).reshape(B, Sq, Hq, Dh), 0, 2, 1, 3)
        k = (lambda x, n, axis: torch.repeat_interleave(x, n, dim=axis))(k_cache, rep, axis=1)
        v = (lambda x, n, axis: torch.repeat_interleave(x, n, dim=axis))(v_cache, rep, axis=1)
        scores = torch.einsum("bhqd,bhkd->bhqk", q, k) * (Dh ** -0.5)
        p = _softmax(scores, axis=-1)
        o = torch.einsum("bhqk,bhkd->bhqd", p, v)
        return (lambda x, *d: x.permute(*d))(o, 0, 2, 1, 3).reshape(B, Sq, Hq * Dh) @ wo

    a = _A_ref(A_x, A_k_cache, A_v_cache, A_wq, A_wo)
    b = _B_ref(B_x, B_k_cache, B_v_cache, B_wq, B_wo)
    return torch.concatenate([a, b], axis=-1)
```

```asm
; @launch grid=(256,1,1) block=(320,1,1) lds=162752
.amdgcn_target "amdgcn-amd-amdhsa--gfx950"
.text
.globl concat_heads__sliding_block_cached__gqa_block_cached__decode_kernel
.p2align 8
.type concat_heads__sliding_block_cached__gqa_block_cached__decode_kernel,@function
concat_heads__sliding_block_cached__gqa_block_cached__decode_kernel:
    s_cmp_ge_u32 s2, 256
    s_cbranch_scc1 L_end
    s_load_dwordx16 s[4:19], s[0:1], 0
    s_load_dwordx8 s[20:27], s[0:1], 64
    s_load_dwordx2 s[28:29], s[0:1], 96
    v_lshrrev_b32 v1, 6, v0
    v_and_b32 v0, 63, v0
    v_readfirstlane_b32 s3, v1
    s_lshr_b32 s30, s2, 4
    s_and_b32 s31, s2, 15
    s_mov_b32 s33, 0x200000
    v_mov_b32 v232, 147456
    s_cmp_eq_u32 s3, 1
    s_cbranch_scc1 L_loader
    s_cmp_eq_u32 s3, 4
    s_cbranch_scc1 L_service
    s_sub_u32 s95, s3, 1
    s_cselect_b32 s95, 0, s95
    v_lshrrev_b32 v1, 3, v0
    v_and_b32 v2, 7, v0
    v_mul_u32_u24 v3, 24, v1
    v_mul_u32_u24 v4, 98304, v1
    v_lshl_add_u32 v4, v2, 4, v4
    s_lshr_b32 s44, s31, 3
    s_mul_i32 s45, s44, 288
    s_mul_i32 s46, s95, 96
    s_add_u32 s45, s45, s46
    s_lshl_b32 s46, s45, 1
    s_lshl_b32 s47, s45, 13
    s_lshl_b32 s48, s30, 9
    s_and_b32 s49, s31, 3
    s_lshl_b32 s49, s49, 7
    s_add_u32 s47, s47, s48
    s_add_u32 s47, s47, s49
    s_mov_b32 s62, 1152
    s_mov_b32 s63, 0x20000
    s_mov_b32 s66, 4718592
    s_mov_b32 s67, 0x20000
    s_bitcmp1_b32 s31, 2
    s_waitcnt lgkmcnt(0)
    s_cselect_b32 s64, s20, s10
    s_cselect_b32 s65, s21, s11
    s_cselect_b32 s60, s14, s4
    s_cselect_b32 s61, s15, s5
    buffer_load_dwordx4 v[24:27], v4, s[64:67], s47 offen nt
    s_add_u32 s47, s47, 8192
    buffer_load_dwordx4 v[28:31], v4, s[64:67], s47 offen nt
    s_add_u32 s47, s47, 8192
    buffer_load_dwordx2 v[72:73], v3, s[60:63], s46 offen offset:0
    buffer_load_dwordx2 v[74:75], v3, s[60:63], s46 offen offset:8
    buffer_load_dwordx2 v[76:77], v3, s[60:63], s46 offen offset:16
    buffer_load_dwordx4 v[32:35], v4, s[64:67], s47 offen nt
    s_add_u32 s47, s47, 8192
    buffer_load_dwordx4 v[36:39], v4, s[64:67], s47 offen nt
    s_add_u32 s47, s47, 8192
    buffer_load_dwordx4 v[40:43], v4, s[64:67], s47 offen nt
    s_add_u32 s47, s47, 8192
    buffer_load_dwordx4 v[44:47], v4, s[64:67], s47 offen nt
    s_add_u32 s47, s47, 8192
    buffer_load_dwordx4 v[48:51], v4, s[64:67], s47 offen nt
    s_add_u32 s47, s47, 8192
    buffer_load_dwordx4 v[52:55], v4, s[64:67], s47 offen nt
    s_add_u32 s47, s47, 8192
    buffer_load_dwordx4 v[56:59], v4, s[64:67], s47 offen nt
    s_add_u32 s47, s47, 8192
    buffer_load_dwordx4 v[60:63], v4, s[64:67], s47 offen nt
    s_add_u32 s47, s47, 8192
    buffer_load_dwordx4 v[64:67], v4, s[64:67], s47 offen nt
    s_add_u32 s47, s47, 8192
    buffer_load_dwordx4 v[68:71], v4, s[64:67], s47 offen nt
    s_load_dword s55, s[28:29], 65536
    s_mov_b32 s56, s28
    s_mov_b32 s57, s29
    s_mov_b32 s58, 1245184
    s_mov_b32 s59, 0x20000
    s_lshl_b32 s50, s44, 7
    s_lshl_b32 s51, s30, 3
    s_and_b32 s52, s31, 7
    s_add_u32 s51, s51, s52
    s_add_u32 s50, s50, s51
    s_mul_i32 s89, s50, 1152
    s_add_u32 s89, s89, 655360
    s_mov_b32 s76, 0xcccccccc
    s_mov_b32 s77, 0xcccccccc
    s_mov_b32 s78, 0xf0f0f0f0
    s_mov_b32 s79, 0xf0f0f0f0
    s_mov_b32 s80, 0xff00ff00
    s_mov_b32 s81, 0xff00ff00
    s_mov_b32 s82, 0xffff0000
    s_mov_b32 s83, 0xffff0000
    s_mov_b32 s96, 0x3fb8aa3b
    s_mov_b32 s97, 0x3db504f3
    s_mov_b32 s98, 0x05040100
    s_mov_b32 s99, 0x07060302
    s_mov_b32 s40, 0x07060503
    s_mov_b32 s41, 0x06050302
    s_mov_b32 s42, 0x05030201
    v_and_b32 v5, 15, v0
    v_lshrrev_b32 v6, 4, v0
    v_and_b32 v7, 7, v5
    v_lshlrev_b32 v7, 1, v7
    v_xor_b32 v7, v7, v6
    v_lshlrev_b32 v7, 4, v7
    v_lshl_add_u32 v196, v5, 8, v7
    v_lshrrev_b32 v7, 2, v5
    v_lshl_add_u32 v7, v6, 2, v7
    v_and_b32 v217, 7, v7
    v_lshlrev_b32 v217, 5, v217
    v_lshl_add_u32 v7, v7, 8, v217
    v_and_b32 v217, 3, v5
    v_lshl_add_u32 v197, v217, 3, v7
    v_lshlrev_b32 v7, 1, v0
    v_add_u32 v230, 155072, v7
    v_mov_b32 v7, 0xffff
    v_mov_b32 v217, 0xffff0000
    v_cndmask_b32 v7, v7, v217, s[76:77]
    v_lshrrev_b32 v217, 2, v5
    v_cmp_eq_u32 vcc, 0, v217
    s_nop 1
    v_cndmask_b32 v213, 0, v7, vcc
    v_cmp_eq_u32 vcc, 1, v217
    s_nop 1
    v_cndmask_b32 v214, 0, v7, vcc
    v_cmp_eq_u32 vcc, 2, v217
    s_nop 1
    v_cndmask_b32 v215, 0, v7, vcc
    v_cmp_eq_u32 vcc, 3, v217
    s_nop 1
    v_cndmask_b32 v216, 0, v7, vcc
    s_lshl_b32 s34, s95, 4
    s_cmp_eq_u32 s95, 2
    s_cselect_b32 s35, 4, 16
    s_cmp_eq_u32 s44, 0
    s_cbranch_scc1 L_sc0
    s_sub_u32 s34, s34, 12
    s_cmp_eq_u32 s95, 0
    s_cselect_b32 s35, 4, 16
    s_cselect_b32 s34, 0, s34
L_sc0:
    s_sub_u32 s52, s35, 1
    v_min_u32 v7, s52, v5
    v_mul_u32_u24 v217, 2304, v6
    v_lshl_add_u32 v234, v7, 4, v217
    v_lshlrev_b32 v7, 5, v5
    v_lshl_add_u32 v235, v6, 4, v7
    s_lshl_b32 s52, s30, 8
    s_bfe_u32 s53, s31, 0x10002
    s_lshl_b32 s53, s53, 7
    s_add_u32 s52, s52, s53
    s_and_b32 s53, s31, 3
    s_lshl_b32 s53, s53, 3
    s_add_u32 s52, s52, s53
    s_mul_i32 s52, s52, 1152
    s_mul_i32 s53, s44, 576
    s_add_u32 s52, s52, s53
    s_lshl_b32 s53, s34, 4
    s_add_u32 s32, s52, s53
    v_lshlrev_b32 v239, 4, v0
    v_add_u32 v236, 148672, v239
    v_lshrrev_b32 v7, 5, v0
    v_lshlrev_b32 v7, 3, v7
    v_add_u32 v237, 149696, v7
    s_lshl_b32 s52, s95, 2
    v_add_u32 v238, s52, v232
    v_and_b32 v7, 1, v0
    v_lshlrev_b32 v7, 8, v7
    v_lshl_add_u32 v7, v6, 4, v7
    v_add_u32 v233, v7, v232
    v_mov_b32 v80, 0
    v_mov_b32 v81, 0
    v_mov_b32 v82, 0
    v_mov_b32 v83, 0
    v_mov_b32 v84, 0
    v_mov_b32 v85, 0
    v_mov_b32 v86, 0
    v_mov_b32 v87, 0
    s_waitcnt vmcnt(8)
    s_barrier
    s_waitcnt vmcnt(10)
    v_perm_b32 v217, v28, v24, s98
    v_perm_b32 v218, v28, v24, s99
    v_perm_b32 v219, v29, v25, s98
    v_perm_b32 v220, v29, v25, s99
    v_perm_b32 v221, v30, v26, s98
    v_perm_b32 v222, v30, v26, s99
    v_perm_b32 v223, v31, v27, s98
    v_perm_b32 v224, v31, v27, s99
    v_dot2_f32_bf16 v80, v217, v72, v80
    v_dot2_f32_bf16 v81, v218, v72, v81
    v_dot2_f32_bf16 v82, v219, v72, v82
    v_dot2_f32_bf16 v83, v220, v72, v83
    v_dot2_f32_bf16 v84, v221, v72, v84
    v_dot2_f32_bf16 v85, v222, v72, v85
    v_dot2_f32_bf16 v86, v223, v72, v86
    v_dot2_f32_bf16 v87, v224, v72, v87
    s_waitcnt vmcnt(8)
    v_perm_b32 v217, v36, v32, s98
    v_perm_b32 v218, v36, v32, s99
    v_perm_b32 v219, v37, v33, s98
    v_perm_b32 v220, v37, v33, s99
    v_perm_b32 v221, v38, v34, s98
    v_perm_b32 v222, v38, v34, s99
    v_perm_b32 v223, v39, v35, s98
    v_perm_b32 v224, v39, v35, s99
    v_dot2_f32_bf16 v80, v217, v73, v80
    v_dot2_f32_bf16 v81, v218, v73, v81
    v_dot2_f32_bf16 v82, v219, v73, v82
    v_dot2_f32_bf16 v83, v220, v73, v83
    v_dot2_f32_bf16 v84, v221, v73, v84
    v_dot2_f32_bf16 v85, v222, v73, v85
    v_dot2_f32_bf16 v86, v223, v73, v86
    v_dot2_f32_bf16 v87, v224, v73, v87
    s_waitcnt vmcnt(6)
    v_perm_b32 v217, v44, v40, s98
    v_perm_b32 v218, v44, v40, s99
    v_perm_b32 v219, v45, v41, s98
    v_perm_b32 v220, v45, v41, s99
    v_perm_b32 v221, v46, v42, s98
    v_perm_b32 v222, v46, v42, s99
    v_perm_b32 v223, v47, v43, s98
    v_perm_b32 v224, v47, v43, s99
    v_dot2_f32_bf16 v80, v217, v74, v80
    v_dot2_f32_bf16 v81, v218, v74, v81
    v_dot2_f32_bf16 v82, v219, v74, v82
    v_dot2_f32_bf16 v83, v220, v74, v83
    v_dot2_f32_bf16 v84, v221, v74, v84
    v_dot2_f32_bf16 v85, v222, v74, v85
    v_dot2_f32_bf16 v86, v223, v74, v86
    v_dot2_f32_bf16 v87, v224, v74, v87
    s_waitcnt vmcnt(4)
    v_perm_b32 v217, v52, v48, s98
    v_perm_b32 v218, v52, v48, s99
    v_perm_b32 v219, v53, v49, s98
    v_perm_b32 v220, v53, v49, s99
    v_perm_b32 v221, v54, v50, s98
    v_perm_b32 v222, v54, v50, s99
    v_perm_b32 v223, v55, v51, s98
    v_perm_b32 v224, v55, v51, s99
    v_dot2_f32_bf16 v80, v217, v75, v80
    v_dot2_f32_bf16 v81, v218, v75, v81
    v_dot2_f32_bf16 v82, v219, v75, v82
    v_dot2_f32_bf16 v83, v220, v75, v83
    v_dot2_f32_bf16 v84, v221, v75, v84
    v_dot2_f32_bf16 v85, v222, v75, v85
    v_dot2_f32_bf16 v86, v223, v75, v86
    v_dot2_f32_bf16 v87, v224, v75, v87
    s_waitcnt vmcnt(2)
    v_perm_b32 v217, v60, v56, s98
    v_perm_b32 v218, v60, v56, s99
    v_perm_b32 v219, v61, v57, s98
    v_perm_b32 v220, v61, v57, s99
    v_perm_b32 v221, v62, v58, s98
    v_perm_b32 v222, v62, v58, s99
    v_perm_b32 v223, v63, v59, s98
    v_perm_b32 v224, v63, v59, s99
    v_dot2_f32_bf16 v80, v217, v76, v80
    v_dot2_f32_bf16 v81, v218, v76, v81
    v_dot2_f32_bf16 v82, v219, v76, v82
    v_dot2_f32_bf16 v83, v220, v76, v83
    v_dot2_f32_bf16 v84, v221, v76, v84
    v_dot2_f32_bf16 v85, v222, v76, v85
    v_dot2_f32_bf16 v86, v223, v76, v86
    v_dot2_f32_bf16 v87, v224, v76, v87
    s_waitcnt vmcnt(0)
    v_perm_b32 v217, v68, v64, s98
    v_perm_b32 v218, v68, v64, s99
    v_perm_b32 v219, v69, v65, s98
    v_perm_b32 v220, v69, v65, s99
    v_perm_b32 v221, v70, v66, s98
    v_perm_b32 v222, v70, v66, s99
    v_perm_b32 v223, v71, v67, s98
    v_perm_b32 v224, v71, v67, s99
    v_dot2_f32_bf16 v80, v217, v77, v80
    v_dot2_f32_bf16 v81, v218, v77, v81
    v_dot2_f32_bf16 v82, v219, v77, v82
    v_dot2_f32_bf16 v83, v220, v77, v83
    v_dot2_f32_bf16 v84, v221, v77, v84
    v_dot2_f32_bf16 v85, v222, v77, v85
    v_dot2_f32_bf16 v86, v223, v77, v86
    v_dot2_f32_bf16 v87, v224, v77, v87
    s_lshl_b32 s52, s95, 11
    s_add_u32 s52, s52, 148672
    v_lshl_add_u32 v7, v0, 5, s52
    v_mov_b32 v2, 1
    ds_write_b128 v7, v[80:83]
    ds_write_b128 v7, v[84:87] offset:16
    s_mov_b64 exec, 1
    ds_add_u32 v232, v2 offset:32
    s_mov_b64 exec, -1
L_w_1:
    ds_read_b32 v1, v232 offset:44
    s_waitcnt lgkmcnt(0)
    v_readfirstlane_b32 s52, v1
    s_cmp_ge_u32 s52, 1
    s_cbranch_scc1 L_ok_2
    s_sub_u32 s33, s33, 1
    s_cbranch_scc1 L_end
    s_sleep 1
    s_branch L_w_1
L_ok_2:
    s_add_u32 s55, s55, 0x9e3779b9
    s_mov_b32 s93, 0
    s_mov_b32 s94, 0
    s_mov_b32 s37, 0
    s_mov_b32 s62, 3
    s_call_b64 s[86:87], L_begin
    s_mov_b32 s60, 1
    s_mov_b32 s90, s95
    s_add_u32 s61, s95, 0
    s_add_u32 s91, s95, 0
    s_cmp_ge_u32 s91, 18
    s_cselect_b32 s52, 18, 0
    s_sub_u32 s91, s91, s52
    s_lshl_b32 s91, s91, 13
    s_mov_b32 s36, 8
    s_call_b64 s[86:87], L_tiles
    s_mov_b32 s60, 2
    s_mov_b32 s90, s95
    s_add_u32 s61, s95, 8
    s_add_u32 s91, s95, 8
    s_cmp_ge_u32 s91, 18
    s_cselect_b32 s52, 18, 0
    s_sub_u32 s91, s91, s52
    s_lshl_b32 s91, s91, 13
    s_mov_b32 s36, 8
    s_call_b64 s[86:87], L_tiles
    s_call_b64 s[86:87], L_dump
    s_mov_b32 s94, 1
L_w_3:
    ds_read_b32 v1, v232 offset:44
    s_waitcnt lgkmcnt(0)
    v_readfirstlane_b32 s52, v1
    s_cmp_ge_u32 s52, 2
    s_cbranch_scc1 L_ok_4
    s_sub_u32 s33, s33, 1
    s_cbranch_scc1 L_end
    s_sleep 1
    s_branch L_w_3
L_ok_4:
    s_call_b64 s[86:87], L_begin
    s_mov_b32 s60, 1
    s_mov_b32 s90, s95
    s_add_u32 s61, s95, 16
    s_add_u32 s91, s95, 16
    s_cmp_ge_u32 s91, 18
    s_cselect_b32 s52, 18, 0
    s_sub_u32 s91, s91, s52
    s_lshl_b32 s91, s91, 13
    s_mov_b32 s36, 60
    s_call_b64 s[86:87], L_tiles
    s_mov_b32 s60, 2
    s_mov_b32 s90, s95
    s_add_u32 s61, s95, 76
    s_add_u32 s91, s95, 4
    s_cmp_ge_u32 s91, 18
    s_cselect_b32 s52, 18, 0
    s_sub_u32 s91, s91, s52
    s_lshl_b32 s91, s91, 13
    s_mov_b32 s36, 60
    s_call_b64 s[86:87], L_tiles
    s_mov_b32 s60, 0
    s_mov_b32 s62, 6
    s_sub_u32 s61, s90, 60
    s_lshl_b32 s61, s61, 1
    s_add_u32 s91, s61, 10
    s_add_u32 s61, s61, 136
    s_cmp_ge_u32 s91, 18
    s_cselect_b32 s52, 18, 0
    s_sub_u32 s91, s91, s52
    s_lshl_b32 s91, s91, 13
    s_mov_b32 s36, 0x7fffffff
    s_call_b64 s[86:87], L_tiles
    s_call_b64 s[86:87], L_dump
    s_call_b64 s[38:39], L_woload
L_wodone:
    s_waitcnt vmcnt(8)
    v_perm_b32 v88, v136, v132, s98
    v_perm_b32 v89, v144, v140, s98
    v_perm_b32 v90, v152, v148, s98
    v_perm_b32 v91, v160, v156, s98
    v_perm_b32 v92, v136, v132, s99
    v_perm_b32 v93, v144, v140, s99
    v_perm_b32 v94, v152, v148, s99
    v_perm_b32 v95, v160, v156, s99
    v_perm_b32 v96, v137, v133, s98
    v_perm_b32 v97, v145, v141, s98
    v_perm_b32 v98, v153, v149, s98
    v_perm_b32 v99, v161, v157, s98
    v_perm_b32 v100, v137, v133, s99
    v_perm_b32 v101, v145, v141, s99
    v_perm_b32 v102, v153, v149, s99
    v_perm_b32 v103, v161, v157, s99
    v_perm_b32 v104, v138, v134, s98
    v_perm_b32 v105, v146, v142, s98
    v_perm_b32 v106, v154, v150, s98
    v_perm_b32 v107, v162, v158, s98
    v_perm_b32 v108, v138, v134, s99
    v_perm_b32 v109, v146, v142, s99
    v_perm_b32 v110, v154, v150, s99
    v_perm_b32 v111, v162, v158, s99
    v_perm_b32 v112, v139, v135, s98
    v_perm_b32 v113, v147, v143, s98
    v_perm_b32 v114, v155, v151, s98
    v_perm_b32 v115, v163, v159, s98
    v_perm_b32 v116, v139, v135, s99
    v_perm_b32 v117, v147, v143, s99
    v_perm_b32 v118, v155, v151, s99
    v_perm_b32 v119, v163, v159, s99
    s_mov_b32 s94, 0
    s_call_b64 s[86:87], L_proj
    s_waitcnt vmcnt(1)
    v_perm_b32 v88, v168, v164, s98
    v_perm_b32 v89, v176, v172, s98
    v_perm_b32 v90, v184, v180, s98
    v_perm_b32 v91, v192, v188, s98
    v_perm_b32 v92, v168, v164, s99
    v_perm_b32 v93, v176, v172, s99
    v_perm_b32 v94, v184, v180, s99
    v_perm_b32 v95, v192, v188, s99
    v_perm_b32 v96, v169, v165, s98
    v_perm_b32 v97, v177, v173, s98
    v_perm_b32 v98, v185, v181, s98
    v_perm_b32 v99, v193, v189, s98
    v_perm_b32 v100, v169, v165, s99
    v_perm_b32 v101, v177, v173, s99
    v_perm_b32 v102, v185, v181, s99
    v_perm_b32 v103, v193, v189, s99
    v_perm_b32 v104, v170, v166, s98
    v_perm_b32 v105, v178, v174, s98
    v_perm_b32 v106, v186, v182, s98
    v_perm_b32 v107, v194, v190, s98
    v_perm_b32 v108, v170, v166, s99
    v_perm_b32 v109, v178, v174, s99
    v_perm_b32 v110, v186, v182, s99
    v_perm_b32 v111, v194, v190, s99
    v_perm_b32 v112, v171, v167, s98
    v_perm_b32 v113, v179, v175, s98
    v_perm_b32 v114, v187, v183, s98
    v_perm_b32 v115, v195, v191, s98
    v_perm_b32 v116, v171, v167, s99
    v_perm_b32 v117, v179, v175, s99
    v_perm_b32 v118, v187, v183, s99
    v_perm_b32 v119, v195, v191, s99
    s_mov_b32 s94, 1
    s_call_b64 s[86:87], L_proj
    s_endpgm
L_begin:
    s_lshl_b32 s52, s94, 9
    v_add_u32 v1, s52, v233
    ds_read_b128 v[8:11], v1 offset:192
    ds_read_b128 v[12:15], v1 offset:256
    ds_read_b128 v[16:19], v1 offset:320
    ds_read_b128 v[20:23], v1 offset:384
    v_mov_b32 v210, 0xff61b1e6
    v_mov_b32 v211, 0
    v_mov_b32 v212, 0
    v_mov_b32 v88, 0
    v_mov_b32 v89, 0
    v_mov_b32 v90, 0
    v_mov_b32 v91, 0
    v_mov_b32 v92, 0
    v_mov_b32 v93, 0
    v_mov_b32 v94, 0
    v_mov_b32 v95, 0
    v_mov_b32 v96, 0
    v_mov_b32 v97, 0
    v_mov_b32 v98, 0
    v_mov_b32 v99, 0
    v_mov_b32 v100, 0
    v_mov_b32 v101, 0
    v_mov_b32 v102, 0
    v_mov_b32 v103, 0
    v_mov_b32 v104, 0
    v_mov_b32 v105, 0
    v_mov_b32 v106, 0
    v_mov_b32 v107, 0
    v_mov_b32 v108, 0
    v_mov_b32 v109, 0
    v_mov_b32 v110, 0
    v_mov_b32 v111, 0
    v_mov_b32 v112, 0
    v_mov_b32 v113, 0
    v_mov_b32 v114, 0
    v_mov_b32 v115, 0
    v_mov_b32 v116, 0
    v_mov_b32 v117, 0
    v_mov_b32 v118, 0
    v_mov_b32 v119, 0
    s_waitcnt lgkmcnt(0)
    s_setpc_b64 s[86:87]
L_tiles:
    s_cmp_ge_u32 s90, s36
    s_cbranch_scc1 L_tiles_ret
L_tile:
    s_add_u32 s92, s61, 1
    s_cmp_eq_u32 s60, 0
    s_cselect_b32 s52, 0x2000, 0
    s_add_u32 s52, s52, s91
    v_add_u32 v202, s52, v197
    v_add_u32 v198, s91, v196
    s_lshl_b32 s52, s90, 7
    v_add_u32 v231, s52, v230
    s_add_u32 s61, s61, s62
    s_lshl_b32 s52, s62, 13
    s_add_u32 s91, s91, s52
    s_cmp_ge_u32 s91, 147456
    s_cselect_b32 s52, 147456, 0
    s_sub_u32 s91, s91, s52
    s_cmp_eq_u32 s60, 2
    s_cbranch_scc1 L_vonly
    v_xor_b32 v199, 64, v198
    v_xor_b32 v200, 128, v198
    v_xor_b32 v201, 192, v198
    v_xor_b32 v203, 32, v202
    v_xor_b32 v204, 64, v202
    v_xor_b32 v205, 96, v202
    v_xor_b32 v206, 128, v202
    v_xor_b32 v207, 160, v202
    v_xor_b32 v208, 192, v202
    v_xor_b32 v209, 224, v202
    s_cmp_ge_u32 s93, s92
    s_cbranch_scc1 L_kok
L_kspin:
    ds_read_b64 v[2:3], v232 offset:0
    s_waitcnt lgkmcnt(0)
    v_readfirstlane_b32 s93, v2
    v_readfirstlane_b32 s53, v3
    s_cmp_ge_u32 s93, s92
    s_cselect_b32 s52, 1, 0
    s_min_u32 s36, s36, s53
    s_cmp_lg_u32 s52, 0
    s_cbranch_scc1 L_kok
    s_cmp_ge_u32 s90, s36
    s_cbranch_scc1 L_tiles_ret
    s_sub_u32 s33, s33, 1
    s_cbranch_scc1 L_end
    s_sleep 1
    s_branch L_kspin
L_kok:
    ds_read_b128 v[24:27], v198 offset:0
    ds_read_b128 v[40:43], v198 offset:4096
    ds_read_b128 v[28:31], v199 offset:0
    ds_read_b128 v[44:47], v199 offset:4096
    ds_read_b128 v[32:35], v200 offset:0
    ds_read_b128 v[48:51], v200 offset:4096
    ds_read_b128 v[36:39], v201 offset:0
    ds_read_b128 v[52:55], v201 offset:4096
    ds_read_b32 v2, v232 offset:0
    s_cmp_eq_u32 s60, 0
    s_cselect_b32 s52, 1, 0
    s_add_u32 s92, s92, s52
    s_add_u32 s90, s90, 3
    v_mov_b32 v4, s92
    s_waitcnt lgkmcnt(7)
    v_mfma_f32_16x16x32_bf16 v[120:123], v[24:27], v[8:11], 0
    v_mfma_f32_16x16x32_bf16 v[124:127], v[40:43], v[8:11], 0
    s_waitcnt lgkmcnt(5)
    v_mfma_f32_16x16x32_bf16 v[120:123], v[28:31], v[12:15], v[120:123]
    v_mfma_f32_16x16x32_bf16 v[124:127], v[44:47], v[12:15], v[124:127]
    s_waitcnt lgkmcnt(3)
    v_mfma_f32_16x16x32_bf16 v[120:123], v[32:35], v[16:19], v[120:123]
    v_mfma_f32_16x16x32_bf16 v[124:127], v[48:51], v[16:19], v[124:127]
    s_waitcnt lgkmcnt(1)
    v_mfma_f32_16x16x32_bf16 v[120:123], v[36:39], v[20:23], v[120:123]
    v_mfma_f32_16x16x32_bf16 v[124:127], v[52:55], v[20:23], v[124:127]
    s_waitcnt lgkmcnt(0)
    v_readfirstlane_b32 s93, v2
    s_nop 0
    s_cmp_ge_u32 s93, s92
    s_cselect_b32 s52, s60, 1
    s_cmp_eq_u32 s52, 0
    s_cbranch_scc0 L_soft
    ds_read_b64_tr_b16 v[56:57], v202 offset:0
    ds_read_b64_tr_b16 v[58:59], v202 offset:4096
    ds_read_b64_tr_b16 v[60:61], v203 offset:0
    ds_read_b64_tr_b16 v[62:63], v203 offset:4096
    ds_read_b64_tr_b16 v[64:65], v204 offset:0
    ds_read_b64_tr_b16 v[66:67], v204 offset:4096
    ds_read_b64_tr_b16 v[68:69], v205 offset:0
    ds_read_b64_tr_b16 v[70:71], v205 offset:4096
    ds_read_b64_tr_b16 v[72:73], v206 offset:0
    ds_read_b64_tr_b16 v[74:75], v206 offset:4096
    ds_read_b64_tr_b16 v[76:77], v207 offset:0
    ds_read_b64_tr_b16 v[78:79], v207 offset:4096
    ds_read_b64_tr_b16 v[80:81], v208 offset:0
    ds_read_b64_tr_b16 v[82:83], v208 offset:4096
    ds_read_b64_tr_b16 v[84:85], v209 offset:0
    ds_read_b64_tr_b16 v[86:87], v209 offset:4096
L_soft:
    v_cndmask_b32 v217, v120, v121, s[76:77]
    v_cndmask_b32 v218, v122, v123, s[76:77]
    v_cndmask_b32 v219, v124, v125, s[76:77]
    v_cndmask_b32 v220, v126, v127, s[76:77]
    v_cndmask_b32 v217, v217, v218, s[78:79]
    v_cndmask_b32 v219, v219, v220, s[78:79]
    v_cndmask_b32 v217, v217, v219, s[80:81]
    v_cvt_pk_bf16_f32 v217, v217, v217
    v_and_b32 v217, 0xffff0000, v217
    v_mul_f32 v217, s97, v217
    v_cvt_pk_bf16_f32 v217, v217, v217
    v_and_b32 v217, 0xffff0000, v217
    v_cmp_gt_f32 vcc, v217, v210
    s_cbranch_vccnz L_newmax
L_maxok:
    s_cmp_eq_u32 s60, 1
    s_cbranch_scc1 L_konly
L_prob:
    v_fma_f32 v217, v217, s96, v211
    v_exp_f32 v217, v217
    s_cmp_eq_u32 s52, 0
    v_add_f32 v212, v212, v217
    v_cvt_pk_bf16_f32 v217, v217, v217
    v_and_b32 v128, v217, v213
    v_and_b32 v129, v217, v214
    v_and_b32 v130, v217, v215
    v_and_b32 v131, v217, v216
    s_cbranch_scc1 L_pv
    s_cmp_ge_u32 s93, s92
    s_cbranch_scc1 L_vok
L_vspin:
    ds_read_b32 v2, v232 offset:0
    s_waitcnt lgkmcnt(0)
    v_readfirstlane_b32 s93, v2
    s_cmp_ge_u32 s93, s92
    s_cbranch_scc1 L_vok
    s_sub_u32 s33, s33, 1
    s_cbranch_scc1 L_end
    s_sleep 1
    s_branch L_vspin
L_vok:
    ds_read_b64_tr_b16 v[56:57], v202 offset:0
    ds_read_b64_tr_b16 v[58:59], v202 offset:4096
    ds_read_b64_tr_b16 v[60:61], v203 offset:0
    ds_read_b64_tr_b16 v[62:63], v203 offset:4096
    ds_read_b64_tr_b16 v[64:65], v204 offset:0
    ds_read_b64_tr_b16 v[66:67], v204 offset:4096
    ds_read_b64_tr_b16 v[68:69], v205 offset:0
    ds_read_b64_tr_b16 v[70:71], v205 offset:4096
    ds_read_b64_tr_b16 v[72:73], v206 offset:0
    ds_read_b64_tr_b16 v[74:75], v206 offset:4096
    ds_read_b64_tr_b16 v[76:77], v207 offset:0
    ds_read_b64_tr_b16 v[78:79], v207 offset:4096
    ds_read_b64_tr_b16 v[80:81], v208 offset:0
    ds_read_b64_tr_b16 v[82:83], v208 offset:4096
    ds_read_b64_tr_b16 v[84:85], v209 offset:0
    ds_read_b64_tr_b16 v[86:87], v209 offset:4096
L_pv:
    s_waitcnt lgkmcnt(14)
    v_mfma_f32_16x16x32_bf16 v[88:91], v[128:131], v[56:59], v[88:91]
    s_waitcnt lgkmcnt(12)
    v_mfma_f32_16x16x32_bf16 v[92:95], v[128:131], v[60:63], v[92:95]
    s_waitcnt lgkmcnt(10)
    v_mfma_f32_16x16x32_bf16 v[96:99], v[128:131], v[64:67], v[96:99]
    s_waitcnt lgkmcnt(8)
    v_mfma_f32_16x16x32_bf16 v[100:103], v[128:131], v[68:71], v[100:103]
    s_waitcnt lgkmcnt(6)
    v_mfma_f32_16x16x32_bf16 v[104:107], v[128:131], v[72:75], v[104:107]
    s_waitcnt lgkmcnt(4)
    v_mfma_f32_16x16x32_bf16 v[108:111], v[128:131], v[76:79], v[108:111]
    s_waitcnt lgkmcnt(2)
    v_mfma_f32_16x16x32_bf16 v[112:115], v[128:131], v[80:83], v[112:115]
    s_waitcnt lgkmcnt(0)
    v_mfma_f32_16x16x32_bf16 v[116:119], v[128:131], v[84:87], v[116:119]
    s_mov_b64 exec, 1
    ds_write_b32 v238, v4 offset:16
    s_mov_b64 exec, -1
    s_cmp_lt_u32 s90, s36
    s_cbranch_scc1 L_tile
L_tiles_ret:
    s_setpc_b64 s[86:87]
L_konly:
    ds_write_b16_d16_hi v231, v217
    s_mov_b64 exec, 1
    ds_write_b32 v238, v4 offset:16
    s_mov_b64 exec, -1
    s_cmp_lt_u32 s90, s36
    s_cbranch_scc1 L_tile
    s_setpc_b64 s[86:87]
L_vonly:
    ds_read_u16 v217, v231
    v_xor_b32 v203, 32, v202
    v_xor_b32 v204, 64, v202
    v_xor_b32 v205, 96, v202
    v_xor_b32 v206, 128, v202
    v_xor_b32 v207, 160, v202
    v_xor_b32 v208, 192, v202
    v_xor_b32 v209, 224, v202
    s_add_u32 s90, s90, 3
    v_mov_b32 v4, s92
    s_mov_b32 s52, 1
    s_waitcnt lgkmcnt(0)
    v_lshlrev_b32 v217, 16, v217
    s_branch L_prob
L_newmax:
    v_max_f32 v218, v217, v210
    s_nop 1
    v_max_f32_dpp v218, v218, v218 row_ror:2 row_mask:0xf bank_mask:0xf
    s_nop 1
    v_max_f32_dpp v218, v218, v218 row_ror:4 row_mask:0xf bank_mask:0xf
    s_nop 1
    v_max_f32_dpp v218, v218, v218 row_ror:8 row_mask:0xf bank_mask:0xf
    v_mov_b32 v219, v218
    s_nop 1
    v_permlane16_swap_b32 v218, v219
    v_max_f32 v218, v218, v219
    v_mov_b32 v219, v218
    s_nop 1
    v_permlane32_swap_b32 v218, v219
    v_max_f32 v218, v218, v219
    v_sub_f32 v219, v210, v218
    v_mul_f32 v219, s96, v219
    v_exp_f32 v219, v219
    v_mov_b32 v210, v218
    v_mul_f32 v211, s96, v218
    v_readlane_b32 s84, v219, 0
    v_readlane_b32 s85, v219, 1
    v_sub_f32 v211, 0, v211
    v_mul_f32 v212, v212, v219
    v_pk_mul_f32 v[88:89], v[88:89], s[84:85]
    v_pk_mul_f32 v[90:91], v[90:91], s[84:85]
    v_pk_mul_f32 v[92:93], v[92:93], s[84:85]
    v_pk_mul_f32 v[94:95], v[94:95], s[84:85]
    v_pk_mul_f32 v[96:97], v[96:97], s[84:85]
    v_pk_mul_f32 v[98:99], v[98:99], s[84:85]
    v_pk_mul_f32 v[100:101], v[100:101], s[84:85]
    v_pk_mul_f32 v[102:103], v[102:103], s[84:85]
    v_pk_mul_f32 v[104:105], v[104:105], s[84:85]
    v_pk_mul_f32 v[106:107], v[106:107], s[84:85]
    v_pk_mul_f32 v[108:109], v[108:109], s[84:85]
    v_pk_mul_f32 v[110:111], v[110:111], s[84:85]
    v_pk_mul_f32 v[112:113], v[112:113], s[84:85]
    v_pk_mul_f32 v[114:115], v[114:115], s[84:85]
    v_pk_mul_f32 v[116:117], v[116:117], s[84:85]
    v_pk_mul_f32 v[118:119], v[118:119], s[84:85]
    s_branch L_maxok
L_dump:
    s_mul_i32 s52, s94, 3168
    s_lshl_b32 s53, s94, 2
    v_add_u32 v3, s53, v232
    s_sub_u32 s51, s90, 2
    s_cmp_eq_u32 s51, s36
    s_cbranch_scc1 L_dm
    s_mul_i32 s53, s95, 1056
    s_add_u32 s52, s52, s53
    v_add_u32 v4, s52, v236
    v_add_u32 v5, s52, v237
    s_branch L_dr
L_dm:
    s_cmp_eq_u32 s95, 0
    s_cselect_b32 s53, 1056, 0
    s_add_u32 s53, s53, s52
    v_add_u32 v4, s53, v236
    v_add_u32 v5, s53, v237
    s_cmp_eq_u32 s95, 2
    s_cselect_b32 s53, 1, 2
    s_mul_i32 s53, s53, 1056
    s_add_u32 s53, s53, s52
    v_add_u32 v40, s53, v236
    v_add_u32 v41, s53, v237
    ds_read_b32 v38, v3 offset:36
    ds_read_b64 v[32:33], v5
    ds_read_b64 v[34:35], v41
    ds_read_b128 v[24:27], v4
    ds_read_b128 v[28:31], v40
L_dr:
    v_add_f32_dpp v7, v212, v212 row_ror:2 row_mask:0xf bank_mask:0xf
    v_mov_b32_dpp v36, v210 quad_perm:[0,0,0,0] row_mask:0x3 bank_mask:0xf
    v_mov_b32 v2, 1
    v_add_f32_dpp v7, v7, v7 row_ror:4 row_mask:0xf bank_mask:0xf
    v_mov_b32_dpp v36, v210 quad_perm:[1,1,1,1] row_mask:0xc bank_mask:0xf
    v_pk_add_f32 v[88:89], v[88:89], v[90:91]
    v_add_f32_dpp v7, v7, v7 row_ror:8 row_mask:0xf bank_mask:0xf
    v_pk_add_f32 v[92:93], v[92:93], v[94:95]
    v_mov_b32 v1, v7
    v_pk_add_f32 v[96:97], v[96:97], v[98:99]
    v_pk_add_f32 v[100:101], v[100:101], v[102:103]
    v_permlane16_swap_b32 v7, v1
    v_pk_add_f32 v[104:105], v[104:105], v[106:107]
    v_add_f32 v7, v7, v1
    v_pk_add_f32 v[108:109], v[108:109], v[110:111]
    v_mov_b32 v1, v7
    v_pk_add_f32 v[112:113], v[112:113], v[114:115]
    v_pk_add_f32 v[116:117], v[116:117], v[118:119]
    v_permlane32_swap_b32 v7, v1
    v_permlane32_swap_b32 v88, v89
    v_add_f32 v7, v7, v1
    v_permlane32_swap_b32 v92, v93
    v_permlane32_swap_b32 v96, v97
    v_permlane32_swap_b32 v100, v101
    v_mov_b32_dpp v37, v7 quad_perm:[0,0,0,0] row_mask:0x3 bank_mask:0xf
    v_permlane32_swap_b32 v104, v105
    v_permlane32_swap_b32 v108, v109
    v_permlane32_swap_b32 v112, v113
    v_mov_b32_dpp v37, v7 quad_perm:[1,1,1,1] row_mask:0xc bank_mask:0xf
    v_permlane32_swap_b32 v116, v117
    v_add_f32 v88, v88, v89
    v_add_f32 v92, v92, v93
    v_add_f32 v96, v96, v97
    v_add_f32 v100, v100, v101
    v_add_f32 v104, v104, v105
    v_add_f32 v108, v108, v109
    v_add_f32 v112, v112, v113
    v_add_f32 v116, v116, v117
    v_permlane16_swap_b32 v88, v92
    v_permlane16_swap_b32 v96, v100
    v_permlane16_swap_b32 v104, v108
    v_permlane16_swap_b32 v112, v116
    v_add_f32 v56, v88, v92
    v_add_f32 v57, v96, v100
    v_add_f32 v58, v104, v108
    v_add_f32 v59, v112, v116
    s_cmp_eq_u32 s51, s36
    s_cbranch_scc1 L_merge
    ds_write_b64 v5, v[36:37]
    ds_write_b128 v4, v[56:59]
    s_mov_b64 exec, 1
    ds_add_u32 v3, v2 offset:36
    s_mov_b64 exec, -1
    s_setpc_b64 s[86:87]
L_mretry:
    s_sub_u32 s33, s33, 1
    s_cbranch_scc1 L_end
    ds_read_b32 v38, v3 offset:36
    ds_read_b64 v[32:33], v5
    ds_read_b64 v[34:35], v41
    ds_read_b128 v[24:27], v4
    ds_read_b128 v[28:31], v40
L_merge:
    s_lshl_b32 s53, s94, 8
    s_add_u32 s53, s53, s2
    s_lshl_b32 s53, s53, 10
    s_add_u32 s53, s53, 131072
    s_waitcnt lgkmcnt(2)
    v_readfirstlane_b32 s52, v38
    v_max3_f32 v6, v32, v34, v36
    s_cmp_lt_u32 s52, 2
    s_cbranch_scc1 L_mretry
    v_sub_f32 v32, v32, v6
    v_sub_f32 v34, v34, v6
    v_sub_f32 v36, v36, v6
    v_mul_f32 v32, s96, v32
    v_mul_f32 v34, s96, v34
    v_mul_f32 v36, s96, v36
    v_exp_f32 v36, v36
    v_exp_f32 v32, v32
    v_exp_f32 v34, v34
    v_mul_f32 v7, v36, v37
    v_mul_f32 v56, v56, v36
    v_mul_f32 v57, v57, v36
    v_mul_f32 v58, v58, v36
    v_mul_f32 v59, v59, v36
    v_fmac_f32 v7, v32, v33
    v_fmac_f32 v7, v34, v35
    s_waitcnt lgkmcnt(0)
    v_rcp_f32 v1, v7
    v_log_f32 v63, v7
    v_fmac_f32 v56, v24, v32
    v_fmac_f32 v57, v25, v32
    v_fmac_f32 v58, v26, v32
    v_fmac_f32 v59, v27, v32
    v_fmac_f32 v63, s96, v6
    v_fmac_f32 v56, v28, v34
    v_fmac_f32 v57, v29, v34
    v_fmac_f32 v58, v30, v34
    v_fmac_f32 v59, v31, v34
    v_mul_f32 v56, v56, v1
    v_mul_f32 v57, v57, v1
    v_mul_f32 v58, v58, v1
    v_mul_f32 v59, v59, v1
    v_perm_b32 v60, v56, v57, s40
    v_perm_b32 v61, v57, v58, s41
    v_perm_b32 v62, v58, v59, s42
    buffer_store_dwordx4 v[60:63], v239, s[56:59], s53 offen sc1
    ds_write_b32 v3, v2 offset:56
    s_setpc_b64 s[86:87]
L_woload:
    s_mov_b32 s37, 1
    s_add_u32 s50, s32, 36864
    s_add_u32 s51, s32, 73728
    s_add_u32 s52, s32, 110592
    s_mov_b32 s68, s12
    s_mov_b32 s69, s13
    s_mov_b32 s70, 4718592
    s_mov_b32 s71, 0x20000
    buffer_load_dwordx4 v[132:135], v234, s[68:71], s32 offen offset:0 nt
    buffer_load_dwordx4 v[136:139], v234, s[68:71], s50 offen offset:0 nt
    buffer_load_dwordx4 v[140:143], v234, s[68:71], s51 offen offset:0 nt
    buffer_load_dwordx4 v[144:147], v234, s[68:71], s52 offen offset:0 nt
    buffer_load_dwordx4 v[148:151], v234, s[68:71], s32 offen offset:1152 nt
    buffer_load_dwordx4 v[152:155], v234, s[68:71], s50 offen offset:1152 nt
    buffer_load_dwordx4 v[156:159], v234, s[68:71], s51 offen offset:1152 nt
    buffer_load_dwordx4 v[160:163], v234, s[68:71], s52 offen offset:1152 nt
    s_mov_b32 s68, s22
    s_mov_b32 s69, s23
    s_mov_b32 s70, 4718592
    s_mov_b32 s71, 0x20000
    buffer_load_dwordx4 v[164:167], v234, s[68:71], s32 offen offset:0 nt
    buffer_load_dwordx4 v[168:171], v234, s[68:71], s50 offen offset:0 nt
    buffer_load_dwordx4 v[172:175], v234, s[68:71], s51 offen offset:0 nt
    buffer_load_dwordx4 v[176:179], v234, s[68:71], s52 offen offset:0 nt
    buffer_load_dwordx4 v[180:183], v234, s[68:71], s32 offen offset:1152 nt
    buffer_load_dwordx4 v[184:187], v234, s[68:71], s50 offen offset:1152 nt
    buffer_load_dwordx4 v[188:191], v234, s[68:71], s51 offen offset:1152 nt
    buffer_load_dwordx4 v[192:195], v234, s[68:71], s52 offen offset:1152 nt
    s_setpc_b64 s[38:39]
L_proj:
    s_lshl_b32 s53, s94, 2
    v_add_u32 v3, s53, v232
    s_lshl_b32 s53, s94, 6
    v_and_b32 v4, 48, v0
    v_add3_u32 v4, v4, s53, v232
    s_mul_i32 s50, s94, 294912
    s_add_u32 s50, s50, s89
    s_lshl_b32 s53, s34, 5
    s_add_u32 s50, s50, s53
    s_bfm_b32 s51, s35, 0
    s_mul_i32 s51, s51, 0x10001
    v_mov_b32 v35, s55
L_pspin:
    ds_read_b32 v1, v3 offset:48
    ds_read_b128 v[24:27], v4 offset:64
    s_waitcnt lgkmcnt(1)
    v_readfirstlane_b32 s52, v1
    s_cmp_lg_u32 s52, 0
    s_cbranch_scc1 L_pok
    s_sub_u32 s33, s33, 1
    s_cbranch_scc1 L_end
    s_branch L_pspin
L_pok:
    s_waitcnt lgkmcnt(0)
    v_mfma_f32_16x16x32_bf16 v[56:59], v[24:27], v[88:91], 0
    v_mfma_f32_16x16x32_bf16 v[72:75], v[24:27], v[104:107], 0
    v_mfma_f32_16x16x32_bf16 v[60:63], v[24:27], v[92:95], 0
    v_mfma_f32_16x16x32_bf16 v[76:79], v[24:27], v[108:111], 0
    v_mfma_f32_16x16x32_bf16 v[64:67], v[24:27], v[96:99], 0
    v_mfma_f32_16x16x32_bf16 v[80:83], v[24:27], v[112:115], 0
    v_mfma_f32_16x16x32_bf16 v[68:71], v[24:27], v[100:103], 0
    v_mfma_f32_16x16x32_bf16 v[84:87], v[24:27], v[116:119], 0
    s_nop 1
    v_cndmask_b32 v28, v56, v72, s[82:83]
    s_nop 0
    v_cndmask_b32 v29, v60, v76, s[82:83]
    s_nop 0
    v_cndmask_b32 v30, v64, v80, s[82:83]
    s_nop 0
    v_cndmask_b32 v31, v68, v84, s[82:83]
    v_perm_b32 v32, v28, v29, s40
    v_perm_b32 v33, v29, v30, s41
    v_perm_b32 v34, v30, v31, s42
    s_mov_b32 exec_lo, s51
    s_mov_b32 exec_hi, 0
    buffer_store_dwordx4 v[32:35], v235, s[56:59], s50 offen sc1
    s_mov_b64 exec, -1
    s_setpc_b64 s[86:87]
L_loader:
    s_setprio 1
    v_lshrrev_b32 v1, 4, v0
    v_lshlrev_b32 v2, 1, v1
    v_xor_b32 v2, v2, v0
    v_and_b32 v2, 15, v2
    v_lshlrev_b32 v2, 4, v2
    v_lshl_add_u32 v2, v1, 8, v2
    v_xor_b32 v3, 0x80, v2
    s_lshl_b32 s47, s30, 23
    s_add_u32 s47, s47, 0x700000
    s_mov_b32 s48, 0xfffff
    s_mul_i32 s67, s30, 393216
    s_lshl_b32 s53, s31, 13
    s_add_u32 s67, s67, s53
    s_mov_b32 s46, s67
    s_mul_i32 s64, s30, 655360
    s_mov_b32 s49, 0
    s_mov_b32 s51, 0
    s_mov_b32 s66, 0
    s_mov_b32 s52, 18
    s_mov_b32 s65, 5
    s_mov_b32 s50, 3
    s_lshl_b32 s53, s30, 8
    s_add_u32 s53, s53, 69632
    s_waitcnt lgkmcnt(0)
    s_mov_b32 s36, s6
    s_mov_b32 s37, s7
    s_mov_b32 s38, 0x8000000
    s_mov_b32 s39, 0x20000
    s_add_u32 s60, s28, s53
    s_addc_u32 s61, s29, 0
    s_load_dword s55, s[28:29], 65536
    s_barrier
    s_and_b32 s44, s46, s48
    s_mul_i32 s54, s51, 8192
    s_add_u32 s54, s54, s44
    s_and_b32 s54, s54, 0x1e000
    s_and_b32 s44, s44, 0xfffe1fff
    s_or_b32 s44, s44, s54
    s_add_u32 s44, s44, s47
    s_add_u32 s51, s51, 1
    s_add_u32 s46, s46, 0x20000
    s_mov_b32 m0, s49
    s_add_u32 s45, s44, 4096
    buffer_load_dwordx4 v2, s[36:39], s44 offen offset:0 nt lds
    buffer_load_dwordx4 v3, s[36:39], s44 offen offset:1024 nt lds
    buffer_load_dwordx4 v2, s[36:39], s44 offen offset:2048 nt lds
    buffer_load_dwordx4 v3, s[36:39], s44 offen offset:3072 nt lds
    s_add_u32 m0, s49, 4096
    s_add_u32 s49, s49, 8192
    buffer_load_dwordx4 v2, s[36:39], s45 offen offset:0 nt lds
    buffer_load_dwordx4 v3, s[36:39], s45 offen offset:1024 nt lds
    buffer_load_dwordx4 v2, s[36:39], s45 offen offset:2048 nt lds
    buffer_load_dwordx4 v3, s[36:39], s45 offen offset:3072 nt lds
    s_cmp_eq_u32 s49, 147456
    s_cselect_b32 s49, 0, s49
    s_and_b32 s44, s46, s48
    s_mul_i32 s54, s51, 8192
    s_add_u32 s54, s54, s44
    s_and_b32 s54, s54, 0x1e000
    s_and_b32 s44, s44, 0xfffe1fff
    s_or_b32 s44, s44, s54
    s_add_u32 s44, s44, s47
    s_add_u32 s51, s51, 1
    s_add_u32 s46, s46, 0x20000
    s_mov_b32 m0, s49
    s_add_u32 s45, s44, 4096
    buffer_load_dwordx4 v2, s[36:39], s44 offen offset:0 nt lds
    buffer_load_dwordx4 v3, s[36:39], s44 offen offset:1024 nt lds
    buffer_load_dwordx4 v2, s[36:39], s44 offen offset:2048 nt lds
    buffer_load_dwordx4 v3, s[36:39], s44 offen offset:3072 nt lds
    s_add_u32 m0, s49, 4096
    s_add_u32 s49, s49, 8192
    buffer_load_dwordx4 v2, s[36:39], s45 offen offset:0 nt lds
    buffer_load_dwordx4 v3, s[36:39], s45 offen offset:1024 nt lds
    buffer_load_dwordx4 v2, s[36:39], s45 offen offset:2048 nt lds
    buffer_load_dwordx4 v3, s[36:39], s45 offen offset:3072 nt lds
    s_cmp_eq_u32 s49, 147456
    s_cselect_b32 s49, 0, s49
    s_and_b32 s44, s46, s48
    s_mul_i32 s54, s51, 8192
    s_add_u32 s54, s54, s44
    s_and_b32 s54, s54, 0x1e000
    s_and_b32 s44, s44, 0xfffe1fff
    s_or_b32 s44, s44, s54
    s_add_u32 s44, s44, s47
    s_add_u32 s51, s51, 1
    s_add_u32 s46, s46, 0x20000
    s_mov_b32 m0, s49
    s_add_u32 s45, s44, 4096
    buffer_load_dwordx4 v2, s[36:39], s44 offen offset:0 nt lds
    buffer_load_dwordx4 v3, s[36:39], s44 offen offset:1024 nt lds
    buffer_load_dwordx4 v2, s[36:39], s44 offen offset:2048 nt lds
    buffer_load_dwordx4 v3, s[36:39], s44 offen offset:3072 nt lds
    s_add_u32 m0, s49, 4096
    s_add_u32 s49, s49, 8192
    buffer_load_dwordx4 v2, s[36:39], s45 offen offset:0 nt lds
    buffer_load_dwordx4 v3, s[36:39], s45 offen offset:1024 nt lds
    buffer_load_dwordx4 v2, s[36:39], s45 offen offset:2048 nt lds
    buffer_load_dwordx4 v3, s[36:39], s45 offen offset:3072 nt lds
    s_cmp_eq_u32 s49, 147456
    s_cselect_b32 s49, 0, s49
L_ld_loop:
    s_sub_u32 s53, s50, 2
    v_mov_b32 v4, s53
    s_waitcnt vmcnt(16)
    s_mov_b64 exec, 1
    ds_max_u32 v232, v4 offset:0
    s_mov_b64 exec, -1
    s_cmp_lt_u32 s50, s52
    s_cbranch_scc1 L_free
L_fspin:
    ds_read_b96 v[8:10], v232 offset:16
    s_waitcnt lgkmcnt(0)
    v_min3_u32 v8, v8, v9, v10
    s_nop 0
    v_readfirstlane_b32 s52, v8
    s_add_u32 s52, s52, 18
    s_cmp_lt_u32 s50, s52
    s_cbranch_scc1 L_free
    v_mov_b32 v5, s50
    s_waitcnt vmcnt(0)
    s_mov_b64 exec, 1
    ds_max_u32 v232, v5 offset:0
    s_mov_b64 exec, -1
    s_sub_u32 s33, s33, 1
    s_cbranch_scc1 L_end
    s_sleep 1
    s_branch L_fspin
L_free:
    s_cmp_eq_u32 s65, 0
    s_cbranch_scc1 L_pass
L_static:
    s_sub_u32 s65, s65, 1
    s_cmp_lg_u32 s50, 134
    s_cbranch_scc1 L_noreq
    s_mov_b32 s62, 1
    s_atomic_add s62, s[60:61], 0x0 glc
L_noreq:
    s_and_b32 s44, s46, s48
    s_mul_i32 s54, s51, 8192
    s_add_u32 s54, s54, s44
    s_and_b32 s54, s54, 0x1e000
    s_and_b32 s44, s44, 0xfffe1fff
    s_or_b32 s44, s44, s54
    s_add_u32 s44, s44, s47
    s_add_u32 s51, s51, 1
    s_add_u32 s46, s46, 0x20000
L_go:
    s_mov_b32 m0, s49
    s_add_u32 s45, s44, 4096
    buffer_load_dwordx4 v2, s[36:39], s44 offen offset:0 nt lds
    buffer_load_dwordx4 v3, s[36:39], s44 offen offset:1024 nt lds
    buffer_load_dwordx4 v2, s[36:39], s44 offen offset:2048 nt lds
    buffer_load_dwordx4 v3, s[36:39], s44 offen offset:3072 nt lds
    s_add_u32 m0, s49, 4096
    s_add_u32 s49, s49, 8192
    s_waitcnt vmcnt(20)
    buffer_load_dwordx4 v2, s[36:39], s45 offen offset:0 nt lds
    buffer_load_dwordx4 v3, s[36:39], s45 offen offset:1024 nt lds
    buffer_load_dwordx4 v2, s[36:39], s45 offen offset:2048 nt lds
    buffer_load_dwordx4 v3, s[36:39], s45 offen offset:3072 nt lds
    s_cmp_eq_u32 s49, 147456
    s_cselect_b32 s49, 0, s49
    s_add_u32 s50, s50, 1
    s_branch L_ld_loop
L_pass:
    s_cmp_ge_u32 s50, 136
    s_cbranch_scc1 L_shared
    s_mov_b32 s51, 0
    s_cmp_eq_u32 s50, 16
    s_cbranch_scc1 L_passB
    s_cmp_eq_u32 s50, 8
    s_cselect_b32 s36, s8, s18
    s_cselect_b32 s37, s9, s19
    s_cselect_b32 s65, 8, 60
    s_mov_b32 s46, s67
    s_branch L_static
L_passB:
    s_mov_b32 s36, s16
    s_mov_b32 s37, s17
    s_mov_b32 s65, 60
    s_lshl_b32 s47, s30, 23
    s_mov_b32 s48, 0x7fffff
    s_lshl_b32 s53, s31, 13
    s_add_u32 s67, s64, s53
    s_mov_b32 s46, s67
    s_branch L_static
L_shared:
    s_bitcmp1_b32 s50, 0
    s_cselect_b32 s36, s18, s16
    s_cselect_b32 s37, s19, s17
    s_cbranch_scc1 L_go
    s_waitcnt lgkmcnt(0)
    s_cmp_ge_u32 s62, 64
    s_cbranch_scc1 L_ld_drain
    s_lshl_b32 s44, s62, 13
    s_mov_b32 s62, 1
    s_atomic_add s62, s[60:61], 0x0 glc
    s_add_u32 s51, s51, 1
    s_add_u32 s44, s44, s64
    s_add_u32 s44, s44, 7864320
    s_and_b32 s44, s44, s48
    s_add_u32 s44, s44, s47
    s_branch L_go
L_ld_drain:
    v_mov_b32 v5, s51
    ds_write_b32 v232, v5 offset:4
    s_sub_u32 s54, s50, 1
    v_mov_b32 v4, s54
    s_waitcnt vmcnt(8)
    s_mov_b64 exec, 1
    ds_max_u32 v232, v4 offset:0
    s_mov_b64 exec, -1
    s_sub_u32 s54, s50, 0
    v_mov_b32 v4, s54
    s_waitcnt vmcnt(0)
    s_mov_b64 exec, 1
    ds_max_u32 v232, v4 offset:0
    s_mov_b64 exec, -1
    s_setprio 0
    s_mov_b32 s94, 1
    s_mov_b32 s88, s2
    s_cmp_lt_u32 s2, 36
    s_cbranch_scc1 L_reduce
    s_mov_b32 s94, 0
    s_sub_u32 s88, s2, 64
    s_cmp_lt_u32 s88, 36
    s_cbranch_scc1 L_reduce
L_ld_done:
L_end:
    s_endpgm
L_reduce:
    s_mov_b32 s56, s28
    s_mov_b32 s57, s29
    s_mov_b32 s58, 1245184
    s_mov_b32 s59, 0x20000
    s_mov_b32 s72, s24
    s_mov_b32 s73, s25
    s_mov_b32 s74, 2304
    s_mov_b32 s75, 0x20000
    v_lshrrev_b32 v1, 2, v0
    v_mul_u32_u24 v1, 1152, v1
    v_and_b32 v2, 3, v0
    v_lshl_add_u32 v1, v2, 4, v1
    s_cmp_ge_u32 s88, 18
    s_cselect_b32 s52, 146304, 0
    s_lshl_b32 s53, s88, 6
    s_add_u32 s52, s52, s53
    s_mul_i32 s53, s94, 294912
    s_add_u32 s52, s52, s53
    s_add_u32 s52, s52, 655360
    s_mul_i32 s50, s94, 1152
    s_lshl_b32 s51, s88, 5
    s_add_u32 s50, s50, s51
    v_lshrrev_b32 v5, 5, v0
    v_bfe_u32 v4, v0, 4, 1
    v_lshl_add_u32 v5, v4, 1, v5
    v_lshl_add_u32 v5, v2, 2, v5
    v_lshlrev_b32 v5, 1, v5
L_w_5:
    ds_read_b32 v6, v232 offset:52
    s_waitcnt lgkmcnt(0)
    v_readfirstlane_b32 s53, v6
    s_cmp_ge_u32 s53, 1
    s_cbranch_scc1 L_ok_6
    s_sub_u32 s33, s33, 1
    s_cbranch_scc1 L_end
    s_sleep 1
    s_branch L_w_5
L_ok_6:
    s_add_u32 s55, s55, 0x9e3779b9
    s_mov_b32 s53, s52
    buffer_load_dwordx4 v[32:35], v1, s[56:59], s53 offen sc1
    s_add_u32 s53, s53, 18432
    buffer_load_dwordx4 v[36:39], v1, s[56:59], s53 offen sc1
    s_add_u32 s53, s53, 18432
    buffer_load_dwordx4 v[40:43], v1, s[56:59], s53 offen sc1
    s_add_u32 s53, s53, 18432
    buffer_load_dwordx4 v[44:47], v1, s[56:59], s53 offen sc1
    s_add_u32 s53, s53, 18432
    buffer_load_dwordx4 v[48:51], v1, s[56:59], s53 offen sc1
    s_add_u32 s53, s53, 18432
    buffer_load_dwordx4 v[52:55], v1, s[56:59], s53 offen sc1
    s_add_u32 s53, s53, 18432
    buffer_load_dwordx4 v[56:59], v1, s[56:59], s53 offen sc1
    s_add_u32 s53, s53, 18432
    buffer_load_dwordx4 v[60:63], v1, s[56:59], s53 offen sc1
    s_mov_b64 vcc, -1
    s_sleep 12
    s_branch L_r1okx
L_r1spin:
    s_mov_b32 s53, s52
    buffer_load_dwordx4 v[64:67], v1, s[56:59], s53 offen sc1
    s_add_u32 s53, s53, 18432
    buffer_load_dwordx4 v[68:71], v1, s[56:59], s53 offen sc1
    s_add_u32 s53, s53, 18432
    buffer_load_dwordx4 v[72:75], v1, s[56:59], s53 offen sc1
    s_add_u32 s53, s53, 18432
    buffer_load_dwordx4 v[76:79], v1, s[56:59], s53 offen sc1
    s_add_u32 s53, s53, 18432
    buffer_load_dwordx4 v[80:83], v1, s[56:59], s53 offen sc1
    s_add_u32 s53, s53, 18432
    buffer_load_dwordx4 v[84:87], v1, s[56:59], s53 offen sc1
    s_add_u32 s53, s53, 18432
    buffer_load_dwordx4 v[88:91], v1, s[56:59], s53 offen sc1
    s_add_u32 s53, s53, 18432
    buffer_load_dwordx4 v[92:95], v1, s[56:59], s53 offen sc1
    s_waitcnt vmcnt(15)
    v_xor_b32 v3, s55, v35
    v_lshlrev_b32 v35, 8, v34
    v_alignbit_b32 v34, v33, v34, 16
    v_alignbit_b32 v33, v32, v33, 8
    s_waitcnt vmcnt(14)
    v_bitop3_b32 v3, v3, v39, s55 bitop3:0xf6
    v_lshlrev_b32 v39, 8, v38
    v_alignbit_b32 v38, v37, v38, 16
    v_alignbit_b32 v37, v36, v37, 8
    v_pk_add_f32 v[34:35], v[34:35], v[38:39]
    v_pk_add_f32 v[32:33], v[32:33], v[36:37]
    s_waitcnt vmcnt(13)
    v_bitop3_b32 v3, v3, v43, s55 bitop3:0xf6
    v_lshlrev_b32 v43, 8, v42
    v_alignbit_b32 v42, v41, v42, 16
    v_alignbit_b32 v41, v40, v41, 8
    v_pk_add_f32 v[34:35], v[34:35], v[42:43]
    v_pk_add_f32 v[32:33], v[32:33], v[40:41]
    s_waitcnt vmcnt(12)
    v_bitop3_b32 v3, v3, v47, s55 bitop3:0xf6
    v_lshlrev_b32 v47, 8, v46
    v_alignbit_b32 v46, v45, v46, 16
    v_alignbit_b32 v45, v44, v45, 8
    v_pk_add_f32 v[34:35], v[34:35], v[46:47]
    v_pk_add_f32 v[32:33], v[32:33], v[44:45]
    s_waitcnt vmcnt(11)
    v_bitop3_b32 v3, v3, v51, s55 bitop3:0xf6
    v_lshlrev_b32 v51, 8, v50
    v_alignbit_b32 v50, v49, v50, 16
    v_alignbit_b32 v49, v48, v49, 8
    v_pk_add_f32 v[34:35], v[34:35], v[50:51]
    v_pk_add_f32 v[32:33], v[32:33], v[48:49]
    s_waitcnt vmcnt(10)
    v_bitop3_b32 v3, v3, v55, s55 bitop3:0xf6
    v_lshlrev_b32 v55, 8, v54
    v_alignbit_b32 v54, v53, v54, 16
    v_alignbit_b32 v53, v52, v53, 8
    v_pk_add_f32 v[34:35], v[34:35], v[54:55]
    v_pk_add_f32 v[32:33], v[32:33], v[52:53]
    s_waitcnt vmcnt(9)
    v_bitop3_b32 v3, v3, v59, s55 bitop3:0xf6
    v_lshlrev_b32 v59, 8, v58
    v_alignbit_b32 v58, v57, v58, 16
    v_alignbit_b32 v57, v56, v57, 8
    v_pk_add_f32 v[34:35], v[34:35], v[58:59]
    v_pk_add_f32 v[32:33], v[32:33], v[56:57]
    s_waitcnt vmcnt(8)
    v_bitop3_b32 v3, v3, v63, s55 bitop3:0xf6
    v_lshlrev_b32 v63, 8, v62
    v_alignbit_b32 v62, v61, v62, 16
    v_alignbit_b32 v61, v60, v61, 8
    v_pk_add_f32 v[34:35], v[34:35], v[62:63]
    v_pk_add_f32 v[32:33], v[32:33], v[60:61]
    v_cmp_ne_u32 vcc, 0, v3
    s_cbranch_vccz L_r1okx
    s_mov_b32 s53, s52
    buffer_load_dwordx4 v[32:35], v1, s[56:59], s53 offen sc1
    s_add_u32 s53, s53, 18432
    buffer_load_dwordx4 v[36:39], v1, s[56:59], s53 offen sc1
    s_add_u32 s53, s53, 18432
    buffer_load_dwordx4 v[40:43], v1, s[56:59], s53 offen sc1
    s_add_u32 s53, s53, 18432
    buffer_load_dwordx4 v[44:47], v1, s[56:59], s53 offen sc1
    s_add_u32 s53, s53, 18432
    buffer_load_dwordx4 v[48:51], v1, s[56:59], s53 offen sc1
    s_add_u32 s53, s53, 18432
    buffer_load_dwordx4 v[52:55], v1, s[56:59], s53 offen sc1
    s_add_u32 s53, s53, 18432
    buffer_load_dwordx4 v[56:59], v1, s[56:59], s53 offen sc1
    s_add_u32 s53, s53, 18432
    buffer_load_dwordx4 v[60:63], v1, s[56:59], s53 offen sc1
    s_waitcnt vmcnt(15)
    v_xor_b32 v3, s55, v67
    v_lshlrev_b32 v67, 8, v66
    v_alignbit_b32 v66, v65, v66, 16
    v_alignbit_b32 v65, v64, v65, 8
    s_waitcnt vmcnt(14)
    v_bitop3_b32 v3, v3, v71, s55 bitop3:0xf6
    v_lshlrev_b32 v71, 8, v70
    v_alignbit_b32 v70, v69, v70, 16
    v_alignbit_b32 v69, v68, v69, 8
    v_pk_add_f32 v[66:67], v[66:67], v[70:71]
    v_pk_add_f32 v[64:65], v[64:65], v[68:69]
    s_waitcnt vmcnt(13)
    v_bitop3_b32 v3, v3, v75, s55 bitop3:0xf6
    v_lshlrev_b32 v75, 8, v74
    v_alignbit_b32 v74, v73, v74, 16
    v_alignbit_b32 v73, v72, v73, 8
    v_pk_add_f32 v[66:67], v[66:67], v[74:75]
    v_pk_add_f32 v[64:65], v[64:65], v[72:73]
    s_waitcnt vmcnt(12)
    v_bitop3_b32 v3, v3, v79, s55 bitop3:0xf6
    v_lshlrev_b32 v79, 8, v78
    v_alignbit_b32 v78, v77, v78, 16
    v_alignbit_b32 v77, v76, v77, 8
    v_pk_add_f32 v[66:67], v[66:67], v[78:79]
    v_pk_add_f32 v[64:65], v[64:65], v[76:77]
    s_waitcnt vmcnt(11)
    v_bitop3_b32 v3, v3, v83, s55 bitop3:0xf6
    v_lshlrev_b32 v83, 8, v82
    v_alignbit_b32 v82, v81, v82, 16
    v_alignbit_b32 v81, v80, v81, 8
    v_pk_add_f32 v[66:67], v[66:67], v[82:83]
    v_pk_add_f32 v[64:65], v[64:65], v[80:81]
    s_waitcnt vmcnt(10)
    v_bitop3_b32 v3, v3, v87, s55 bitop3:0xf6
    v_lshlrev_b32 v87, 8, v86
    v_alignbit_b32 v86, v85, v86, 16
    v_alignbit_b32 v85, v84, v85, 8
    v_pk_add_f32 v[66:67], v[66:67], v[86:87]
    v_pk_add_f32 v[64:65], v[64:65], v[84:85]
    s_waitcnt vmcnt(9)
    v_bitop3_b32 v3, v3, v91, s55 bitop3:0xf6
    v_lshlrev_b32 v91, 8, v90
    v_alignbit_b32 v90, v89, v90, 16
    v_alignbit_b32 v89, v88, v89, 8
    v_pk_add_f32 v[66:67], v[66:67], v[90:91]
    v_pk_add_f32 v[64:65], v[64:65], v[88:89]
    s_waitcnt vmcnt(8)
    v_bitop3_b32 v3, v3, v95, s55 bitop3:0xf6
    v_lshlrev_b32 v95, 8, v94
    v_alignbit_b32 v94, v93, v94, 16
    v_alignbit_b32 v93, v92, v93, 8
    v_pk_add_f32 v[66:67], v[66:67], v[94:95]
    v_pk_add_f32 v[64:65], v[64:65], v[92:93]
    v_cmp_ne_u32 vcc, 0, v3
    s_cbranch_vccz L_r1oky
    s_sub_u32 s33, s33, 1
    s_cbranch_scc1 L_end
    s_branch L_r1spin
L_r1oky:
    s_nop 0
    v_add_f32_dpp v24, v64, v64 row_ror:4 row_mask:0xf bank_mask:0xf
    v_add_f32_dpp v25, v65, v65 row_ror:4 row_mask:0xf bank_mask:0xf
    v_add_f32_dpp v26, v66, v66 row_ror:4 row_mask:0xf bank_mask:0xf
    v_add_f32_dpp v27, v67, v67 row_ror:4 row_mask:0xf bank_mask:0xf
    s_branch L_r1tail
L_r1okx:
    s_nop 0
    v_add_f32_dpp v24, v32, v32 row_ror:4 row_mask:0xf bank_mask:0xf
    v_add_f32_dpp v25, v33, v33 row_ror:4 row_mask:0xf bank_mask:0xf
    v_add_f32_dpp v26, v34, v34 row_ror:4 row_mask:0xf bank_mask:0xf
    v_add_f32_dpp v27, v35, v35 row_ror:4 row_mask:0xf bank_mask:0xf
L_r1tail:
    v_add_f32_dpp v24, v24, v24 row_ror:8 row_mask:0xf bank_mask:0xf
    v_add_f32_dpp v25, v25, v25 row_ror:8 row_mask:0xf bank_mask:0xf
    v_add_f32_dpp v26, v26, v26 row_ror:8 row_mask:0xf bank_mask:0xf
    v_add_f32_dpp v27, v27, v27 row_ror:8 row_mask:0xf bank_mask:0xf
    s_nop 0
    v_permlane32_swap_b32 v24, v25
    v_permlane32_swap_b32 v26, v27
    v_add_f32 v24, v24, v25
    v_add_f32 v26, v26, v27
    s_nop 1
    v_permlane16_swap_b32 v24, v26
    v_add_f32 v24, v24, v26
    v_cvt_pk_bf16_f32 v24, v24, v24
    s_cbranch_vccnz L_r1spin
    s_mov_b32 exec_lo, 0x000f000f
    s_mov_b32 exec_hi, 0x000f000f
    buffer_store_short v24, v5, s[72:75], s50 offen sc1
    s_mov_b64 exec, -1
    s_cmp_lg_u32 s2, 0
    s_cbranch_scc1 L_ld_done
    v_mov_b32 v1, s55
    v_mov_b32 v2, 65536
    s_mov_b64 exec, 1
    buffer_store_dword v1, v2, s[56:59], 0 offen sc1
    s_mov_b64 exec, -1
    s_branch L_ld_done
L_service:
    v_mov_b32 v2, 0
    v_mov_b32 v3, -1
    v_mov_b32 v4, 0
    v_mov_b32 v5, 1
    v_mov_b32 v6, 2
    v_mov_b32 v12, 0
    v_mov_b32 v13, 0
    v_mov_b32 v14, 0
    v_mov_b32 v15, 0
    ds_write_b64 v232, v[2:3] offset:0
    ds_write_b96 v232, v[4:6] offset:16
    ds_write_b128 v232, v[12:15] offset:32
    ds_write_b128 v232, v[12:15] offset:48
    v_lshlrev_b32 v7, 4, v0
    v_mov_b32 v16, -1
    v_mov_b32 v17, -1
    v_mov_b32 v18, -1
    v_mov_b32 v19, -1
    s_lshl_b32 s49, s2, 10
    s_add_u32 s49, s49, 131072
    s_add_u32 s50, s49, 262144
    s_waitcnt lgkmcnt(0)
    s_load_dword s55, s[28:29], 65536
    s_mov_b32 s56, s28
    s_mov_b32 s57, s29
    s_mov_b32 s58, 1245184
    s_mov_b32 s59, 0x20000
    s_cmp_lg_u32 s31, 0
    s_cbranch_scc1 L_noz
    s_lshl_b32 s51, s30, 8
    s_add_u32 s51, s51, 69632
    s_mov_b64 exec, 1
    buffer_store_dword v2, v2, s[56:59], s51 offen sc1
    s_mov_b64 exec, -1
L_noz:
    buffer_store_dwordx4 v[16:19], v7, s[56:59], s49 offen sc1
    buffer_store_dwordx4 v[16:19], v7, s[56:59], s50 offen sc1
    s_barrier
    s_mov_b32 s96, 0x3fb8aa3b
    s_mov_b32 s40, 0x07060503
    s_mov_b32 s41, 0x06050302
    s_mov_b32 s42, 0x05030201
    v_and_b32 v5, 15, v0
    v_lshrrev_b32 v6, 4, v0
    v_lshlrev_b32 v5, 10, v5
    v_lshl_add_u32 v8, v6, 5, v5
    v_mul_u32_u24 v10, 1536, v6
    v_and_b32 v11, 15, v0
    v_lshl_add_u32 v10, v11, 4, v10
    v_add_u32 v10, v10, v232
    s_lshl_b32 s54, s30, 12
    s_lshl_b32 s53, s31, 8
    s_add_u32 s53, s54, s53
L_w_7:
    ds_read_b32 v1, v232 offset:32
    s_waitcnt lgkmcnt(0)
    v_readfirstlane_b32 s52, v1
    s_cmp_ge_u32 s52, 3
    s_cbranch_scc1 L_ok_8
    s_sub_u32 s33, s33, 1
    s_cbranch_scc1 L_end
    s_sleep 1
    s_branch L_w_7
L_ok_8:
    ds_read_b128 v[24:27], v10 offset:1216
    ds_read_b128 v[28:31], v10 offset:1472
    ds_read_b128 v[32:35], v10 offset:1728
    ds_read_b128 v[36:39], v10 offset:1984
    ds_read_b128 v[40:43], v10 offset:2240
    ds_read_b128 v[44:47], v10 offset:2496
    s_add_u32 s55, s55, 0x9e3779b9
    v_mov_b32 v51, s55
    s_waitcnt lgkmcnt(0)
    v_pk_add_f32 v[24:25], v[24:25], v[36:37]
    v_pk_add_f32 v[26:27], v[26:27], v[38:39]
    v_pk_add_f32 v[28:29], v[28:29], v[40:41]
    v_pk_add_f32 v[30:31], v[30:31], v[42:43]
    v_pk_add_f32 v[32:33], v[32:33], v[44:45]
    v_pk_add_f32 v[34:35], v[34:35], v[46:47]
    v_pk_add_f32 v[24:25], v[24:25], v[28:29]
    v_pk_add_f32 v[26:27], v[26:27], v[30:31]
    v_pk_add_f32 v[24:25], v[24:25], v[32:33]
    v_pk_add_f32 v[26:27], v[26:27], v[34:35]
    v_mov_b32 v28, v24
    v_mov_b32 v29, v25
    v_mov_b32 v30, v26
    v_mov_b32 v31, v27
    v_permlane16_swap_b32 v24, v28
    v_permlane16_swap_b32 v25, v29
    v_permlane16_swap_b32 v26, v30
    v_permlane16_swap_b32 v27, v31
    v_pk_add_f32 v[24:25], v[24:25], v[28:29]
    v_pk_add_f32 v[26:27], v[26:27], v[30:31]
    v_mov_b32 v28, v24
    v_mov_b32 v29, v25
    v_mov_b32 v30, v26
    v_mov_b32 v31, v27
    v_permlane32_swap_b32 v24, v28
    v_permlane32_swap_b32 v25, v29
    v_permlane32_swap_b32 v26, v30
    v_permlane32_swap_b32 v27, v31
    v_pk_add_f32 v[24:25], v[24:25], v[28:29]
    v_pk_add_f32 v[26:27], v[26:27], v[30:31]
    v_add_u32 v24, 0x80, v24
    v_add_u32 v25, 0x80, v25
    v_add_u32 v26, 0x80, v26
    v_add_u32 v27, 0x80, v27
    v_perm_b32 v48, v24, v25, s40
    v_perm_b32 v49, v25, v26, s41
    v_perm_b32 v50, v26, v27, s42
    s_waitcnt vmcnt(0)
    s_mov_b64 exec, 0xffff
    buffer_store_dwordx4 v[48:51], v7, s[56:59], s53 offen sc1
    s_mov_b64 exec, -1
L_qspin0:
    buffer_load_dwordx4 v[56:59], v7, s[56:59], s54 offen offset:0 sc1
    buffer_load_dwordx4 v[60:63], v7, s[56:59], s54 offen offset:2048 sc1
    s_waitcnt vmcnt(1)
    v_xor_b32 v4, s55, v59
    v_lshlrev_b32 v59, 8, v58
    v_alignbit_b32 v58, v57, v58, 16
    v_alignbit_b32 v57, v56, v57, 8
    v_and_b32 v56, 0xffffff00, v56
    v_and_b32 v57, 0xffffff00, v57
    v_and_b32 v58, 0xffffff00, v58
    s_waitcnt vmcnt(0)
    v_bitop3_b32 v4, v4, v63, s55 bitop3:0xf6
    v_lshlrev_b32 v63, 8, v62
    v_alignbit_b32 v62, v61, v62, 16
    v_alignbit_b32 v61, v60, v61, 8
    v_and_b32 v60, 0xffffff00, v60
    v_and_b32 v61, 0xffffff00, v61
    v_and_b32 v62, 0xffffff00, v62
    v_cmp_ne_u32 vcc, 0, v4
    v_pk_add_f32 v[56:57], v[56:57], v[60:61]
    v_pk_add_f32 v[58:59], v[58:59], v[62:63]
    s_cbranch_vccz L_qready0
    s_sub_u32 s33, s33, 1
    s_cbranch_scc1 L_end
    s_sleep 1
    s_branch L_qspin0
L_qready0:
    v_cvt_pk_bf16_f32 v56, v56, v57
    v_cvt_pk_bf16_f32 v57, v58, v59
    v_lshl_add_u32 v4, v0, 3, v232
    v_mov_b32 v1, 1
    ds_write_b64 v4, v[56:57] offset:192
    ds_write_b32 v232, v1 offset:44
    s_sleep 40
L_qspin1:
    buffer_load_dwordx4 v[56:59], v7, s[56:59], s54 offen offset:1024 sc1
    buffer_load_dwordx4 v[60:63], v7, s[56:59], s54 offen offset:3072 sc1
    s_waitcnt vmcnt(1)
    v_xor_b32 v4, s55, v59
    v_lshlrev_b32 v59, 8, v58
    v_alignbit_b32 v58, v57, v58, 16
    v_alignbit_b32 v57, v56, v57, 8
    v_and_b32 v56, 0xffffff00, v56
    v_and_b32 v57, 0xffffff00, v57
    v_and_b32 v58, 0xffffff00, v58
    s_waitcnt vmcnt(0)
    v_bitop3_b32 v4, v4, v63, s55 bitop3:0xf6
    v_lshlrev_b32 v63, 8, v62
    v_alignbit_b32 v62, v61, v62, 16
    v_alignbit_b32 v61, v60, v61, 8
    v_and_b32 v60, 0xffffff00, v60
    v_and_b32 v61, 0xffffff00, v61
    v_and_b32 v62, 0xffffff00, v62
    v_cmp_ne_u32 vcc, 0, v4
    v_pk_add_f32 v[56:57], v[56:57], v[60:61]
    v_pk_add_f32 v[58:59], v[58:59], v[62:63]
    s_cbranch_vccz L_qready1
    s_sub_u32 s33, s33, 1
    s_cbranch_scc1 L_end
    s_sleep 1
    s_branch L_qspin1
L_qready1:
    v_cvt_pk_bf16_f32 v56, v56, v57
    v_cvt_pk_bf16_f32 v57, v58, v59
    v_lshl_add_u32 v4, v0, 3, v232
    v_mov_b32 v1, 2
    ds_write_b64 v4, v[56:57] offset:704
    ds_write_b32 v232, v1 offset:44
    s_mov_b32 s94, 0
L_svc_branch:
    s_lshl_b32 s46, s94, 2
    v_add_u32 v3, s46, v232
    s_lshl_b32 s46, s94, 6
    v_and_b32 v13, 48, v0
    v_add3_u32 v13, v13, s46, v232
    s_lshl_b32 s48, s94, 4
    s_add_u32 s48, s48, s30
    s_lshl_b32 s48, s48, 14
    s_add_u32 s48, s48, 131072
    s_and_b32 s50, s31, 7
    s_lshl_b32 s50, s50, 7
    s_add_u32 s48, s48, s50
    s_cmp_lg_u32 s94, 0
    s_cbranch_scc1 L_svc_b
L_w_9:
    ds_read_b32 v1, v232 offset:0
    s_waitcnt lgkmcnt(0)
    v_readfirstlane_b32 s52, v1
    s_cmp_ge_u32 s52, 130
    s_cbranch_scc1 L_ok_10
    s_sub_u32 s33, s33, 1
    s_cbranch_scc1 L_end
    s_sleep 16
    s_branch L_w_9
L_ok_10:
L_svc_b:
L_w_11:
    ds_read_b32 v1, v3 offset:56
    s_waitcnt lgkmcnt(0)
    v_readfirstlane_b32 s52, v1
    s_cmp_ge_u32 s52, 1
    s_cbranch_scc1 L_ok_12
    s_sub_u32 s33, s33, 1
    s_cbranch_scc1 L_end
    s_sleep 1
    s_branch L_w_11
L_ok_12:
    s_sleep 16
L_h1spin:
    buffer_load_dwordx4 v[64:67], v8, s[56:59], s48 offen sc1
    buffer_load_dwordx4 v[68:71], v8, s[56:59], s48 offen offset:16 sc1
    s_waitcnt vmcnt(1)
    v_max_f32_dpp v14, v67, v67 row_ror:8 row_mask:0xf bank_mask:0xf
    v_max3_u32 v15, v64, v65, v66
    v_alignbit_b32 v49, v64, v65, 8
    v_max_f32_dpp v14, v14, v14 row_ror:4 row_mask:0xf bank_mask:0xf
    v_alignbit_b32 v50, v65, v66, 16
    v_lshlrev_b32 v51, 8, v66
    v_max_f32_dpp v14, v14, v14 row_ror:2 row_mask:0xf bank_mask:0xf
    s_waitcnt vmcnt(0)
    v_max3_u32 v15, v15, v67, v68
    v_max_f32_dpp v14, v14, v14 row_ror:1 row_mask:0xf bank_mask:0xf
    v_max3_u32 v15, v15, v69, v70
    v_sub_f32 v14, v67, v14
    v_max_u32 v15, v15, v71
    v_exp_f32 v14, v14
    v_cmp_eq_u32 vcc, -1, v15
    v_alignbit_b32 v53, v68, v69, 8
    v_alignbit_b32 v54, v69, v70, 16
    v_lshlrev_b32 v55, 8, v70
    s_cbranch_vccz L_h1ok
    s_sub_u32 s33, s33, 1
    s_cbranch_scc1 L_end
    s_sleep 1
    s_branch L_h1spin
L_h1ok:
    v_mul_f32 v48, v64, v14
    v_mul_f32 v49, v49, v14
    v_mul_f32 v50, v50, v14
    v_mul_f32 v51, v51, v14
    v_mul_f32 v52, v68, v14
    v_mul_f32 v53, v53, v14
    v_mul_f32 v54, v54, v14
    v_mul_f32 v55, v55, v14
    v_add_f32_dpp v14, v14, v14 row_ror:8 row_mask:0xf bank_mask:0xf
    v_add_f32_dpp v48, v48, v48 row_ror:8 row_mask:0xf bank_mask:0xf
    v_add_f32_dpp v49, v49, v49 row_ror:8 row_mask:0xf bank_mask:0xf
    v_add_f32_dpp v50, v50, v50 row_ror:8 row_mask:0xf bank_mask:0xf
    v_add_f32_dpp v51, v51, v51 row_ror:8 row_mask:0xf bank_mask:0xf
    v_add_f32_dpp v52, v52, v52 row_ror:8 row_mask:0xf bank_mask:0xf
    v_add_f32_dpp v53, v53, v53 row_ror:8 row_mask:0xf bank_mask:0xf
    v_add_f32_dpp v54, v54, v54 row_ror:8 row_mask:0xf bank_mask:0xf
    v_add_f32_dpp v55, v55, v55 row_ror:8 row_mask:0xf bank_mask:0xf
    v_add_f32_dpp v14, v14, v14 row_ror:4 row_mask:0xf bank_mask:0xf
    v_add_f32_dpp v48, v48, v48 row_ror:4 row_mask:0xf bank_mask:0xf
    v_add_f32_dpp v49, v49, v49 row_ror:4 row_mask:0xf bank_mask:0xf
    v_add_f32_dpp v50, v50, v50 row_ror:4 row_mask:0xf bank_mask:0xf
    v_add_f32_dpp v51, v51, v51 row_ror:4 row_mask:0xf bank_mask:0xf
    v_add_f32_dpp v52, v52, v52 row_ror:4 row_mask:0xf bank_mask:0xf
    v_add_f32_dpp v53, v53, v53 row_ror:4 row_mask:0xf bank_mask:0xf
    v_add_f32_dpp v54, v54, v54 row_ror:4 row_mask:0xf bank_mask:0xf
    v_add_f32_dpp v55, v55, v55 row_ror:4 row_mask:0xf bank_mask:0xf
    v_add_f32_dpp v14, v14, v14 row_ror:2 row_mask:0xf bank_mask:0xf
    v_add_f32_dpp v48, v48, v48 row_ror:2 row_mask:0xf bank_mask:0xf
    v_add_f32_dpp v49, v49, v49 row_ror:2 row_mask:0xf bank_mask:0xf
    v_add_f32_dpp v50, v50, v50 row_ror:2 row_mask:0xf bank_mask:0xf
    v_add_f32_dpp v51, v51, v51 row_ror:2 row_mask:0xf bank_mask:0xf
    v_add_f32_dpp v52, v52, v52 row_ror:2 row_mask:0xf bank_mask:0xf
    v_add_f32_dpp v53, v53, v53 row_ror:2 row_mask:0xf bank_mask:0xf
    v_add_f32_dpp v54, v54, v54 row_ror:2 row_mask:0xf bank_mask:0xf
    v_add_f32_dpp v55, v55, v55 row_ror:2 row_mask:0xf bank_mask:0xf
    v_add_f32_dpp v14, v14, v14 row_ror:1 row_mask:0xf bank_mask:0xf
    v_add_f32_dpp v48, v48, v48 row_ror:1 row_mask:0xf bank_mask:0xf
    v_add_f32_dpp v49, v49, v49 row_ror:1 row_mask:0xf bank_mask:0xf
    v_add_f32_dpp v50, v50, v50 row_ror:1 row_mask:0xf bank_mask:0xf
    v_add_f32_dpp v51, v51, v51 row_ror:1 row_mask:0xf bank_mask:0xf
    v_add_f32_dpp v52, v52, v52 row_ror:1 row_mask:0xf bank_mask:0xf
    v_add_f32_dpp v53, v53, v53 row_ror:1 row_mask:0xf bank_mask:0xf
    v_add_f32_dpp v54, v54, v54 row_ror:1 row_mask:0xf bank_mask:0xf
    v_add_f32_dpp v55, v55, v55 row_ror:1 row_mask:0xf bank_mask:0xf
    v_rcp_f32 v14, v14
    s_nop 0
    v_mul_f32 v48, v48, v14
    v_mul_f32 v49, v49, v14
    v_mul_f32 v50, v50, v14
    v_mul_f32 v51, v51, v14
    v_mul_f32 v52, v52, v14
    v_mul_f32 v53, v53, v14
    v_mul_f32 v54, v54, v14
    v_mul_f32 v55, v55, v14
    v_cvt_pk_bf16_f32 v60, v48, v49
    v_cvt_pk_bf16_f32 v61, v50, v51
    v_cvt_pk_bf16_f32 v62, v52, v53
    v_cvt_pk_bf16_f32 v63, v54, v55
    s_mov_b32 exec_lo, 0x00010001
    s_mov_b32 exec_hi, 0x00010001
    ds_write_b128 v13, v[60:63] offset:64
    ds_write_b32 v3, v1 offset:48
    s_mov_b64 exec, -1
    s_add_u32 s94, s94, 1
    s_cmp_lt_u32 s94, 2
    s_cbranch_scc1 L_svc_branch
    s_endpgm
.section .rodata,"a"
.p2align 6
.amdhsa_kernel concat_heads__sliding_block_cached__gqa_block_cached__decode_kernel
  .amdhsa_next_free_vgpr 240
  .amdhsa_next_free_sgpr 102
  .amdhsa_accum_offset 240
  .amdhsa_group_segment_fixed_size 0
  .amdhsa_kernarg_size 104
  .amdhsa_user_sgpr_count 2
  .amdhsa_user_sgpr_kernarg_segment_ptr 1
  .amdhsa_system_sgpr_workgroup_id_x 1
  .amdhsa_float_denorm_mode_32 3
.end_amdhsa_kernel
```
